```python
import torch

def _softmax(x, axis=-1):
    return torch.softmax(x, dim=axis)
def _gelu(x):
    return torch.nn.functional.gelu(x, approximate="tanh")
def _silu(x):
    return torch.nn.functional.silu(x)
def _sigmoid(x):
    return torch.sigmoid(x)
def _layernorm(x, axis=-1, eps=1e-5):
    m = x.mean(dim=axis, keepdim=True)
    v = x.var(dim=axis, keepdim=True, unbiased=False)
    return (x - m) / torch.sqrt(v + eps)
def _scatter_add(tgt, idx, src, axis=0):
    return tgt.clone().index_add_(axis, idx, src)
def _segment_sum(src, seg, n):
    out = torch.zeros((n,) + src.shape[1:], dtype=src.dtype)
    return out.index_add_(0, seg, src)
def _pad(x, pw):
    flat = tuple(v for pair in reversed(pw) for v in pair)
    return torch.nn.functional.pad(x, flat)

kernel_name = 'gather_scatter__spectral_conv_sgc__graph'

def setup_inputs():

    _w = (lambda a: (lambda t: t.to(torch.bfloat16) if t.is_floating_point() else t)(torch.as_tensor(a)))
    N, deg, D = 50000, 16, 64
    E = N * deg
    rs = (lambda lo, hi, *s: torch.randint(lo, hi, s))(0, N, E).to(torch.int64)
    rd = (lambda lo, hi, *s: torch.randint(lo, hi, s))(0, N, E).to(torch.int64)
    loop = torch.arange(N).to(torch.int64)
    src = torch.cat([rs, loop])
    dst = torch.cat([rd, loop])
    deg_cnt = torch.bincount(dst, minlength=N).to(float)
    dis = 1.0 / (lambda _x: torch.sqrt(torch.as_tensor(_x)))(deg_cnt)
    return {
        "x": _w((lambda *s: torch.randn(*s, dtype=torch.bfloat16) * 0.05)(N, D)),
        "src": _w(src),
        "dst": _w(dst),
        "norm": _w((dis[src] * dis[dst]).to(float)),
        "w": _w((lambda *s: torch.randn(*s, dtype=torch.bfloat16) * 0.05)(D, D)),
    }

def reference(x, src, dst, norm, w):
    N = x.shape[0]
    h = x
    for _ in range(2):
        msg = h[src] * norm[:, None]
        h = _segment_sum(msg, dst, N)
    return h @ w
```

```asm
; @launch kernel=gather_scatter__spectral_conv_sgc__graph_kernel grid=(256,1,1) block=(832,1,1) lds=28672
; @launch kernel=hops_kernel grid=(256,1,1) block=(1024,1,1) lds=152896
.amdgcn_target "amdgcn-amd-amdhsa--gfx950"
.text
.globl gather_scatter__spectral_conv_sgc__graph_kernel
.p2align 8
.type gather_scatter__spectral_conv_sgc__graph_kernel,@function
gather_scatter__spectral_conv_sgc__graph_kernel:
s_cmp_ge_u32 s2, 256
s_cbranch_scc1 L_k1_end
s_getpc_b64 s[36:37]
L_k1_pc0:
s_sub_u32 s36, s36, L_k1_pc0-gather_scatter__spectral_conv_sgc__graph_kernel
s_subb_u32 s37, s37, 0
v_and_b32 v68, 63, v0
v_lshlrev_b32 v68, 4, v68
s_mov_b32 s38, L_k1_codeend-gather_scatter__spectral_conv_sgc__graph_kernel-16
v_min_u32 v69, s38, v68
v_and_b32 v69, -16, v69
global_load_dwordx4 v[64:67], v69, s[36:37]
v_add_u32 v68, 1024, v68
v_min_u32 v69, s38, v68
v_and_b32 v69, -16, v69
global_load_dwordx4 v[64:67], v69, s[36:37]
v_add_u32 v68, 1024, v68
s_load_dwordx2 s[4:5], s[0:1], 8
s_load_dwordx2 s[6:7], s[0:1], 16
s_load_dwordx2 s[8:9], s[0:1], 24
s_load_dwordx2 s[10:11], s[0:1], 56
s_mul_i32 s12, s2, 13312
v_lshl_add_u32 v1, v0, 4, s12
v_lshrrev_b32 v2, 1, v1
v_mov_b32 v3, 0
v_lshlrev_b32 v4, 2, v0
v_cmp_gt_u32 vcc, 256, v0
s_and_saveexec_b64 s[14:15], vcc
s_cbranch_execz L_k1_nz
ds_write_b32 v4, v3
L_k1_nz:
s_mov_b64 exec, s[14:15]
s_waitcnt lgkmcnt(0)
s_mov_b32 s20, s6
s_mov_b32 s21, s7
s_mov_b32 s22, 3400000
s_mov_b32 s23, 0x20000
buffer_load_dwordx4 v[8:11], v1, s[20:23], 0 offen
s_mov_b32 s16, s4
s_mov_b32 s17, s5
s_mov_b32 s18, 3400000
s_mov_b32 s19, 0x20000
s_mov_b32 s24, s8
s_mov_b32 s25, s9
s_mov_b32 s26, 1700000
s_mov_b32 s27, 0x20000
s_mov_b32 s28, s10
s_mov_b32 s29, s11
s_mov_b32 s30, 25165824
s_mov_b32 s31, 0x20000
s_mov_b32 s13, 3400000
v_cmp_gt_u32 s[32:33], s13, v1
v_mov_b32 v18, 1
s_mov_b32 s34, 0x05040100
s_mov_b32 s35, 0x05040302
s_cmp_lg_u32 s2, 0
s_cbranch_scc1 L_k1_nb
v_lshlrev_b32 v5, 7, v0
v_add_u32 v5, 7602176, v5
v_cmp_gt_u32 vcc, 48, v0
s_and_saveexec_b64 s[14:15], vcc
s_cbranch_execz L_k1_nb2
buffer_store_dword v3, v5, s[28:31], 0 offen sc1
L_k1_nb2:
s_mov_b64 exec, s[14:15]
L_k1_nb:
s_barrier
buffer_load_dwordx4 v[12:15], v1, s[16:19], 0 offen
buffer_load_dwordx2 v[16:17], v2, s[24:27], 0 offen
s_getpc_b64 s[36:37]
L_k1_pc:
s_add_u32 s36, s36, hops_kernel-L_k1_pc
s_addc_u32 s37, s37, 0
v_lshrrev_b32 v68, 6, v0
s_lshr_b32 s38, s2, 3
v_add_u32 v68, s38, v68
v_and_b32 v68, 7, v68
v_lshlrev_b32 v68, 10, v68
v_and_b32 v69, 63, v0
v_lshl_add_u32 v68, v69, 4, v68
s_mov_b32 s38, L_f_codeend-hops_kernel-16
v_min_u32 v68, s38, v68
v_and_b32 v68, -16, v68
global_load_dwordx4 v[68:71], v68, s[36:37]
s_waitcnt vmcnt(3)
v_lshrrev_b32 v20, 4, v8
v_lshrrev_b32 v21, 4, v9
v_lshrrev_b32 v22, 4, v10
v_lshrrev_b32 v23, 4, v11
v_mul_u32_u24 v20, 21475, v20
v_mul_u32_u24 v21, 21475, v21
v_mul_u32_u24 v22, 21475, v22
v_mul_u32_u24 v23, 21475, v23
v_lshrrev_b32 v20, 18, v20
v_lshrrev_b32 v21, 18, v21
v_lshrrev_b32 v22, 18, v22
v_lshrrev_b32 v23, 18, v23
v_lshlrev_b32 v20, 2, v20
v_lshlrev_b32 v21, 2, v21
v_lshlrev_b32 v22, 2, v22
v_lshlrev_b32 v23, 2, v23
s_mov_b64 exec, s[32:33]
s_cbranch_execz L_k1_noat
v_cmp_eq_u32 vcc, v20, v23
v_cmp_eq_u32 s[36:37], v21, v22
s_and_b64 vcc, vcc, s[36:37]
v_cmp_eq_u32 s[36:37], v20, v21
s_and_b64 vcc, vcc, s[36:37]
s_cmp_eq_u64 vcc, exec
s_cbranch_scc0 L_k1_plain
s_mov_b64 s[36:37], exec
L_k1_agg:
s_mov_b64 exec, s[36:37]
v_readfirstlane_b32 s38, v20
s_nop 1
v_cmp_eq_u32 vcc, s38, v20
s_andn2_b64 s[36:37], s[36:37], vcc
s_mov_b64 exec, vcc
s_bcnt1_i32_b64 s39, vcc
s_lshl_b32 s39, s39, 2
v_mbcnt_lo_u32_b32 v28, vcc_lo, 0
v_mbcnt_hi_u32_b32 v28, vcc_hi, v28
v_lshlrev_b32 v28, 2, v28
v_mov_b32 v29, s39
v_mov_b32 v30, s38
v_cmp_eq_u32 vcc, 0, v28
s_and_saveexec_b64 s[40:41], vcc
ds_add_rtn_u32 v31, v30, v29
s_waitcnt lgkmcnt(0)
s_nop 0
v_readfirstlane_b32 s39, v31
s_mov_b64 exec, s[40:41]
s_nop 1
v_add_u32 v24, s39, v28
v_add_u32 v25, 1, v24
v_add_u32 v26, 2, v24
v_add_u32 v27, 3, v24
s_cmp_lg_u64 s[36:37], 0
s_cbranch_scc1 L_k1_agg
s_branch L_k1_noat
L_k1_plain:
ds_add_rtn_u32 v24, v20, v18
ds_add_rtn_u32 v25, v21, v18
ds_add_rtn_u32 v26, v22, v18
ds_add_rtn_u32 v27, v23, v18
L_k1_noat:
s_mov_b64 exec, -1
s_waitcnt lgkmcnt(0)
s_barrier
v_and_b32 v19, 63, v0
v_lshlrev_b32 v19, 4, v19
ds_read_b128 v[40:43], v19
s_waitcnt lgkmcnt(0)
v_add_u32 v44, v40, v41
v_add_u32 v45, v42, v43
v_add_u32 v44, v44, v45
v_mov_b32 v45, v44
s_nop 1
v_add_u32_dpp v45, v45, v45 row_shr:1 row_mask:0xf bank_mask:0xf
s_nop 1
v_add_u32_dpp v45, v45, v45 row_shr:2 row_mask:0xf bank_mask:0xf
s_nop 1
v_add_u32_dpp v45, v45, v45 row_shr:4 row_mask:0xf bank_mask:0xf
s_nop 1
v_add_u32_dpp v45, v45, v45 row_shr:8 row_mask:0xf bank_mask:0xf
s_nop 1
v_add_u32_dpp v45, v45, v45 row_bcast:15 row_mask:0xa bank_mask:0xf
s_nop 1
v_add_u32_dpp v45, v45, v45 row_bcast:31 row_mask:0xc bank_mask:0xf
v_sub_u32 v48, v45, v44
v_add_u32 v49, v48, v40
v_add_u32 v50, v49, v41
v_add_u32 v51, v50, v42
ds_write_b128 v19, v[48:51] offset:1024
ds_read_b32 v56, v20 offset:1024
ds_read_b32 v57, v21 offset:1024
ds_read_b32 v58, v22 offset:1024
ds_read_b32 v59, v23 offset:1024
v_cmp_gt_u32 vcc, 64, v0
s_and_saveexec_b64 s[14:15], vcc
s_cbranch_execz L_k1_nc
v_lshl_or_b32 v52, v40, 16, v48
v_lshl_or_b32 v53, v41, 16, v49
v_lshl_or_b32 v54, v42, 16, v50
v_lshl_or_b32 v55, v43, 16, v51
s_lshl_b32 s12, s2, 10
s_add_u32 s12, s12, 7340032
buffer_store_dwordx4 v[52:55], v19, s[28:31], s12 offen sc1
L_k1_nc:
s_mov_b64 exec, s[14:15]
s_waitcnt lgkmcnt(0)
v_add_lshl_u32 v56, v56, v24, 3
v_add_lshl_u32 v57, v57, v25, 3
v_add_lshl_u32 v58, v58, v26, 3
v_add_lshl_u32 v59, v59, v27, 3
s_waitcnt vmcnt(1)
v_lshlrev_b32 v32, 7, v12
v_perm_b32 v33, v8, v16, s34
v_lshlrev_b32 v34, 7, v13
v_perm_b32 v35, v9, v16, s35
v_lshlrev_b32 v36, 7, v14
v_perm_b32 v37, v10, v17, s34
v_lshlrev_b32 v38, 7, v15
v_perm_b32 v39, v11, v17, s35
s_mov_b64 exec, s[32:33]
s_cbranch_execz L_k1_now
ds_write_b64 v56, v[32:33] offset:2048
ds_write_b64 v57, v[34:35] offset:2048
ds_write_b64 v58, v[36:37] offset:2048
ds_write_b64 v59, v[38:39] offset:2048
L_k1_now:
s_mov_b64 exec, -1
s_waitcnt lgkmcnt(0)
s_barrier
v_lshlrev_b32 v19, 4, v0
ds_read_b128 v[60:63], v19 offset:2048
ds_read_b128 v[64:67], v19 offset:15360
s_mul_i32 s12, s2, 26624
s_add_u32 s13, s12, 13312
s_waitcnt lgkmcnt(1)
buffer_store_dwordx4 v[60:63], v19, s[28:31], s12 offen sc1
s_waitcnt lgkmcnt(0)
buffer_store_dwordx4 v[64:67], v19, s[28:31], s13 offen sc1
L_k1_end:
s_endpgm
L_k1_codeend:
.globl hops_kernel
.p2align 8
.type hops_kernel,@function
hops_kernel:
s_cmp_ge_u32 s2, 256
s_cbranch_scc1 L_f_end
s_load_dwordx2 s[40:41], s[0:1], 56
s_load_dwordx2 s[42:43], s[0:1], 0
s_load_dwordx2 s[44:45], s[0:1], 40
s_load_dwordx2 s[46:47], s[0:1], 32
s_and_b32 s20, s2, 7
s_lshl_b32 s20, s20, 5
s_lshr_b32 s30, s2, 3
s_add_u32 s20, s20, s30
s_mul_i32 s21, s20, 3125
s_add_u32 s21, s21, 255
s_add_u32 s22, s21, 3125
s_lshr_b32 s21, s21, 8
s_lshr_b32 s22, s22, 8
s_sub_u32 s22, s22, s21
v_lshrrev_b32 v1, 6, v0
s_nop 0
v_readfirstlane_b32 s23, v1
v_and_b32 v1, 63, v0
v_and_b32 v2, 15, v1
v_lshrrev_b32 v3, 4, v1
s_mov_b32 s31, 0
s_mov_b32 s58, 1
s_mov_b32 s57, 0
s_waitcnt lgkmcnt(0)
s_mov_b32 s8, s40
s_mov_b32 s9, s41
s_mov_b32 s10, 25165824
s_mov_b32 s11, 0x20000
s_lshl_b32 s30, s23, 4
v_lshl_add_u32 v40, v3, 2, s30
s_lshl_b32 s54, s20, 2
s_add_u32 s54, s54, 7340032
v_lshl_add_u32 v41, v40, 10, s54
v_lshrrev_b32 v43, 2, v0
v_lshl_add_u32 v44, v43, 10, s54
buffer_load_dword v4, v41, s[8:11], 0 offen offset:0
buffer_load_dword v5, v41, s[8:11], 0 offen offset:1024
buffer_load_dword v6, v41, s[8:11], 0 offen offset:2048
buffer_load_dword v7, v41, s[8:11], 0 offen offset:3072
buffer_load_dword v116, v44, s[8:11], 0 offen
s_mov_b32 s30, 26624
v_mul_lo_u32 v101, v40, s30
v_mul_lo_u32 v118, v43, s30
s_sub_u32 s4, s42, 3072
s_subb_u32 s5, s43, 0
s_mov_b32 s6, 6403072
s_mov_b32 s7, 0x20000
s_add_u32 s12, s40, 8388608
s_addc_u32 s13, s41, 0
s_mov_b32 s14, 6400000
s_mov_b32 s15, 0x20000
s_mov_b32 s16, s46
s_mov_b32 s17, s47
s_mov_b32 s18, 8192
s_mov_b32 s19, 0x20000
s_cmp_lg_u32 s23, 0
s_cbranch_scc1 L_f_nozero0
v_mov_b32 v60, 0
v_lshlrev_b32 v61, 2, v1
ds_write_b32 v61, v60
ds_write_b32 v61, v60 offset:64
L_f_nozero0:
v_lshlrev_b32 v98, 3, v2
v_mov_b32 v102, 1
v_mov_b32 v103, 0x10000
s_mov_b32 s48, 0xffff
s_mov_b32 s55, 0xffffff
v_lshrrev_b32 v119, 4, v0
v_lshlrev_b32 v119, 2, v119
v_mov_b32 v40, 0
v_mov_b32 v41, 0
v_mov_b32 v42, 0
v_mov_b32 v43, 0
v_mov_b32 v44, 0
v_mov_b32 v45, 0
v_mov_b32 v46, 0
v_mov_b32 v47, 0
v_mov_b32 v48, 0
v_mov_b32 v49, 0
v_mov_b32 v50, 0
v_mov_b32 v51, 0
v_mov_b32 v52, 0
v_mov_b32 v53, 0
v_mov_b32 v54, 0
v_mov_b32 v55, 0
v_lshrrev_b32 v56, 3, v1
v_and_b32 v57, 7, v1
v_xor_b32 v88, 0, v57
v_lshlrev_b32 v88, 4, v88
v_add_u32 v88, 3072, v88
v_xor_b32 v89, 2, v57
v_lshlrev_b32 v89, 4, v89
v_add_u32 v89, 2048, v89
v_xor_b32 v90, 4, v57
v_lshlrev_b32 v90, 4, v90
v_add_u32 v90, 1024, v90
v_xor_b32 v91, 6, v57
v_lshlrev_b32 v91, 4, v91
v_add_u32 v91, 0, v91
v_bfe_u32 v58, v1, 2, 2
v_and_b32 v59, 3, v1
s_lshl_b32 s49, s23, 13
s_add_u32 s49, s49, 46400
v_xor_b32 v60, 0, v58
v_lshlrev_b32 v60, 5, v60
v_lshl_add_u32 v60, v58, 10, v60
v_lshl_add_u32 v60, v3, 7, v60
v_lshl_add_u32 v60, v59, 3, v60
v_add_u32 v92, s49, v60
v_xor_b32 v60, 1, v58
v_lshlrev_b32 v60, 5, v60
v_lshl_add_u32 v60, v58, 10, v60
v_lshl_add_u32 v60, v3, 7, v60
v_lshl_add_u32 v60, v59, 3, v60
v_add_u32 v93, s49, v60
v_xor_b32 v60, 2, v58
v_lshlrev_b32 v60, 5, v60
v_lshl_add_u32 v60, v58, 10, v60
v_lshl_add_u32 v60, v3, 7, v60
v_lshl_add_u32 v60, v59, 3, v60
v_add_u32 v94, s49, v60
v_xor_b32 v60, 3, v58
v_lshlrev_b32 v60, 5, v60
v_lshl_add_u32 v60, v58, 10, v60
v_lshl_add_u32 v60, v3, 7, v60
v_lshl_add_u32 v60, v59, 3, v60
v_add_u32 v95, s49, v60
v_add_u32 v104, 16, v2
v_lshlrev_b32 v105, 4, v56
v_add_u32 v105, 1344, v105
v_lshlrev_b32 v106, 4, v3
v_add_u32 v106, 19776, v106
s_waitcnt lgkmcnt(0)
s_barrier
s_waitcnt vmcnt(0)
v_lshrrev_b32 v60, 16, v4
v_min_u32 v60, 16, v60
v_and_b32 v61, s48, v4
v_lshl_add_u32 v61, v61, 3, v101
v_lshl_or_b32 v4, v60, 24, v61
v_lshrrev_b32 v60, 16, v5
v_min_u32 v60, 16, v60
v_and_b32 v61, s48, v5
v_lshl_add_u32 v61, v61, 3, v101
v_add_u32 v61, 26624, v61
v_lshl_or_b32 v5, v60, 24, v61
v_lshrrev_b32 v60, 16, v6
v_min_u32 v60, 16, v60
v_and_b32 v61, s48, v6
v_lshl_add_u32 v61, v61, 3, v101
v_add_u32 v61, 53248, v61
v_lshl_or_b32 v6, v60, 24, v61
v_lshrrev_b32 v60, 16, v7
v_min_u32 v60, 16, v60
v_and_b32 v61, s48, v7
v_lshl_add_u32 v61, v61, 3, v101
v_add_u32 v61, 79872, v61
v_lshl_or_b32 v7, v60, 24, v61
v_lshrrev_b32 v60, 24, v4
v_cmp_lt_u32 s[32:33], v2, v60
v_and_b32 v61, s55, v4
v_add_u32 v61, v61, v98
v_mov_b32 v62, 2130706432
s_nop 0
v_cndmask_b32 v61, v62, v61, s[32:33]
buffer_load_dwordx2 v[8:9], v61, s[8:11], 0 offen
v_lshrrev_b32 v60, 24, v5
v_cmp_lt_u32 s[34:35], v2, v60
v_and_b32 v61, s55, v5
v_add_u32 v61, v61, v98
v_mov_b32 v62, 2130706432
s_nop 0
v_cndmask_b32 v61, v62, v61, s[34:35]
buffer_load_dwordx2 v[10:11], v61, s[8:11], 0 offen
v_lshrrev_b32 v60, 24, v6
v_cmp_lt_u32 s[36:37], v2, v60
v_and_b32 v61, s55, v6
v_add_u32 v61, v61, v98
v_mov_b32 v62, 2130706432
s_nop 0
v_cndmask_b32 v61, v62, v61, s[36:37]
buffer_load_dwordx2 v[12:13], v61, s[8:11], 0 offen
v_lshrrev_b32 v60, 24, v7
v_cmp_lt_u32 s[38:39], v2, v60
v_and_b32 v61, s55, v7
v_add_u32 v61, v61, v98
v_mov_b32 v62, 2130706432
s_nop 0
v_cndmask_b32 v61, v62, v61, s[38:39]
buffer_load_dwordx2 v[14:15], v61, s[8:11], 0 offen
v_lshrrev_b32 v60, 16, v116
v_and_b32 v61, s48, v116
v_lshl_add_u32 v118, v61, 3, v118
v_mov_b32 v116, v60
v_add_u32 v61, -1, v60
v_ashrrev_i32 v61, 4, v61
v_and_b32 v62, 3, v0
v_cmp_eq_u32 vcc, 0, v62
v_cmp_lt_i32 s[52:53], 0, v61
s_and_b64 vcc, vcc, s[52:53]
v_mov_b32 v117, 0
v_mov_b32 v62, 256
s_and_saveexec_b64 s[52:53], vcc
s_cbranch_execz L_f_noalloc
ds_add_rtn_u32 v117, v62, v61
s_waitcnt lgkmcnt(0)
L_f_noalloc:
s_mov_b64 exec, s[52:53]
s_nop 1
v_mov_b32_dpp v117, v117 quad_perm:[0,0,0,0] row_mask:0xf bank_mask:0xf
s_mov_b32 s24, 0
v_add_u32 v61, -1, v116
v_ashrrev_i32 v61, 4, v61
v_subrev_u32 v62, s24, v117
v_sub_u32 v63, 1, v62
v_max_i32 v63, 1, v63
v_and_b32 v64, 3, v0
v_add_u32 v63, v63, v64
v_sub_u32 v64, 256, v62
v_min_i32 v61, v61, v64
L_f_bld0loop:
v_cmp_le_i32 vcc, v63, v61
s_and_saveexec_b64 s[52:53], vcc
s_cbranch_execz L_f_bld0done
v_lshlrev_b32 v64, 4, v63
v_sub_u32 v64, v116, v64
v_min_u32 v64, 16, v64
v_lshl_add_u32 v65, v63, 7, v118
v_lshl_or_b32 v64, v64, 24, v65
v_add_u32 v65, v62, v63
v_lshlrev_b32 v65, 2, v65
ds_write_b32 v65, v64 offset:316
v_add_u32 v63, 4, v63
s_branch L_f_bld0loop
L_f_bld0done:
s_mov_b64 exec, -1
s_waitcnt lgkmcnt(0)
s_barrier
v_mov_b32 v60, 256
ds_read_b32 v60, v60
ds_read_b32 v114, v119 offset:320
ds_read_b32 v115, v119 offset:576
s_waitcnt lgkmcnt(0)
v_readfirstlane_b32 s50, v60
v_lshrrev_b32 v60, 4, v0
s_nop 1
v_cmp_gt_u32 vcc, s50, v60
v_add_u32 v60, 64, v60
v_cmp_gt_u32 s[52:53], s50, v60
s_nop 0
v_cndmask_b32 v114, 0, v114, vcc
v_cndmask_b32 v115, 0, v115, s[52:53]
v_lshrrev_b32 v60, 24, v114
v_cmp_lt_u32 s[40:41], v2, v60
v_and_b32 v61, s55, v114
v_add_u32 v61, v61, v98
v_mov_b32 v62, 2130706432
s_nop 0
v_cndmask_b32 v61, v62, v61, s[40:41]
buffer_load_dwordx2 v[16:17], v61, s[8:11], 0 offen
v_lshrrev_b32 v60, 24, v115
v_cmp_lt_u32 s[42:43], v2, v60
v_and_b32 v61, s55, v115
v_add_u32 v61, v61, v98
v_mov_b32 v62, 2130706432
s_nop 0
v_cndmask_b32 v61, v62, v61, s[42:43]
buffer_load_dwordx2 v[18:19], v61, s[8:11], 0 offen
L_f_slots:
s_waitcnt vmcnt(5)
v_lshrrev_b32 v32, 20, v9
v_subrev_u32 v32, s21, v32
v_mul_hi_u32_u24 v110, 2656, v8
v_lshlrev_b32 v60, 2, v32
v_lshl_add_u32 v60, v110, 6, v60
s_mov_b64 exec, s[32:33]
ds_add_rtn_u32 v24, v60, v102
s_mov_b64 exec, -1
s_waitcnt vmcnt(4)
v_lshrrev_b32 v33, 20, v11
v_subrev_u32 v33, s21, v33
v_mul_hi_u32_u24 v111, 2656, v10
v_lshlrev_b32 v60, 2, v33
v_lshl_add_u32 v60, v111, 6, v60
s_mov_b64 exec, s[34:35]
ds_add_rtn_u32 v25, v60, v102
s_mov_b64 exec, -1
s_waitcnt vmcnt(3)
v_lshrrev_b32 v34, 20, v13
v_subrev_u32 v34, s21, v34
v_mul_hi_u32_u24 v112, 2656, v12
v_lshlrev_b32 v60, 2, v34
v_lshl_add_u32 v60, v112, 6, v60
s_mov_b64 exec, s[36:37]
ds_add_rtn_u32 v26, v60, v102
s_mov_b64 exec, -1
s_waitcnt vmcnt(2)
v_lshrrev_b32 v35, 20, v15
v_subrev_u32 v35, s21, v35
v_mul_hi_u32_u24 v113, 2656, v14
v_lshlrev_b32 v60, 2, v35
v_lshl_add_u32 v60, v113, 6, v60
s_mov_b64 exec, s[38:39]
ds_add_rtn_u32 v27, v60, v102
s_mov_b64 exec, -1
s_waitcnt vmcnt(1)
v_lshrrev_b32 v36, 20, v17
v_subrev_u32 v36, s21, v36
v_mul_hi_u32_u24 v114, 2656, v16
v_lshlrev_b32 v60, 2, v36
v_lshl_add_u32 v60, v114, 6, v60
s_mov_b64 exec, s[40:41]
ds_add_rtn_u32 v28, v60, v102
s_mov_b64 exec, -1
s_waitcnt vmcnt(0)
v_lshrrev_b32 v37, 20, v19
v_subrev_u32 v37, s21, v37
v_mul_hi_u32_u24 v115, 2656, v18
v_lshlrev_b32 v60, 2, v37
v_lshl_add_u32 v60, v115, 6, v60
s_mov_b64 exec, s[42:43]
ds_add_rtn_u32 v29, v60, v102
s_mov_b64 exec, -1
s_cmp_lg_u32 s31, 0
s_cbranch_scc1 L_f_nx1
s_lshr_b32 s56, s2, 3
s_lshl_b32 s56, s56, 14
s_add_u32 s56, s56, 3072
v_lshlrev_b32 v127, 4, v0
buffer_load_dwordx4 v[120:123], v127, s[4:7], s56 offen
s_add_u32 s56, s56, 524288
buffer_load_dwordx4 v[120:123], v127, s[4:7], s56 offen
s_add_u32 s56, s56, 524288
L_f_nx1:
v_bfe_u32 v60, v9, 16, 4
v_lshlrev_b32 v60, v60, v103
v_and_or_b32 v9, v9, s48, v60
v_lshlrev_b32 v60, 2, v110
v_lshl_add_u32 v32, v32, 4, v60
v_bfe_u32 v60, v11, 16, 4
v_lshlrev_b32 v60, v60, v103
v_and_or_b32 v11, v11, s48, v60
v_lshlrev_b32 v60, 2, v111
v_lshl_add_u32 v33, v33, 4, v60
v_bfe_u32 v60, v13, 16, 4
v_lshlrev_b32 v60, v60, v103
v_and_or_b32 v13, v13, s48, v60
v_lshlrev_b32 v60, 2, v112
v_lshl_add_u32 v34, v34, 4, v60
v_bfe_u32 v60, v15, 16, 4
v_lshlrev_b32 v60, v60, v103
v_and_or_b32 v15, v15, s48, v60
v_lshlrev_b32 v60, 2, v113
v_lshl_add_u32 v35, v35, 4, v60
v_bfe_u32 v60, v17, 16, 4
v_lshlrev_b32 v60, v60, v103
v_and_or_b32 v17, v17, s48, v60
v_lshlrev_b32 v60, 2, v114
v_lshl_add_u32 v36, v36, 4, v60
v_bfe_u32 v60, v19, 16, 4
v_lshlrev_b32 v60, v60, v103
v_and_or_b32 v19, v19, s48, v60
v_lshlrev_b32 v60, 2, v115
v_lshl_add_u32 v37, v37, 4, v60
s_waitcnt lgkmcnt(0)
s_barrier
v_and_b32 v60, 3, v1
v_lshlrev_b32 v60, 6, v60
v_lshrrev_b32 v61, 2, v1
v_lshl_add_u32 v60, v61, 2, v60
ds_read_b32 v62, v60
s_waitcnt lgkmcnt(0)
v_add_u32_dpp v64, v62, v62 quad_perm:[1,0,3,2] row_mask:0xf bank_mask:0xf
s_nop 1
v_add_u32_dpp v64, v64, v64 quad_perm:[2,3,0,1] row_mask:0xf bank_mask:0xf
v_sub_u32 v65, 0, v64
v_and_b32 v65, 31, v65
v_and_b32 v66, 3, v1
v_cmp_eq_u32 vcc, 3, v66
s_nop 1
v_cndmask_b32 v65, 0, v65, vcc
v_add_u32 v65, v62, v65
v_mov_b32 v66, v65
s_nop 1
v_add_u32_dpp v66, v66, v66 row_shr:1 row_mask:0xf bank_mask:0xf
s_nop 1
v_add_u32_dpp v66, v66, v66 row_shr:2 row_mask:0xf bank_mask:0xf
s_nop 1
v_add_u32_dpp v66, v66, v66 row_shr:4 row_mask:0xf bank_mask:0xf
s_nop 1
v_add_u32_dpp v66, v66, v66 row_shr:8 row_mask:0xf bank_mask:0xf
s_nop 1
v_add_u32_dpp v66, v66, v66 row_bcast:15 row_mask:0xa bank_mask:0xf
s_nop 1
v_add_u32_dpp v66, v66, v66 row_bcast:31 row_mask:0xc bank_mask:0xf
v_sub_u32 v67, v66, v65
s_nop 0
v_readlane_b32 s26, v66, 63
s_cmp_lg_u32 s31, 0
s_cbranch_scc1 L_f_fits
s_cmp_gt_u32 s50, 128
s_cselect_b32 s27, 1, 0
s_cmp_gt_u32 s26, 4608
s_cselect_b32 s27, 1, s27
s_cmp_eq_u32 s27, 0
s_cbranch_scc1 L_f_fits
s_mov_b32 s31, 1
L_f_slow0:
s_mov_b32 s25, 0
s_waitcnt lgkmcnt(0)
s_barrier
s_cmp_lg_u32 s23, 0
s_cbranch_scc1 L_f_nz1
v_mov_b32 v60, 0
v_lshlrev_b32 v61, 2, v1
ds_write_b32 v61, v60
L_f_nz1:
s_waitcnt lgkmcnt(0)
s_barrier
v_lshrrev_b32 v60, 24, v4
v_cmp_lt_u32 s[32:33], v2, v60
v_and_b32 v61, s55, v4
v_add_u32 v61, v61, v98
v_mov_b32 v62, 2130706432
s_nop 0
v_cndmask_b32 v61, v62, v61, s[32:33]
buffer_load_dwordx2 v[8:9], v61, s[8:11], 0 offen
v_lshrrev_b32 v60, 24, v5
v_cmp_lt_u32 s[34:35], v2, v60
v_and_b32 v61, s55, v5
v_add_u32 v61, v61, v98
v_mov_b32 v62, 2130706432
s_nop 0
v_cndmask_b32 v61, v62, v61, s[34:35]
buffer_load_dwordx2 v[10:11], v61, s[8:11], 0 offen
v_lshrrev_b32 v60, 24, v6
v_cmp_lt_u32 s[36:37], v2, v60
v_and_b32 v61, s55, v6
v_add_u32 v61, v61, v98
v_mov_b32 v62, 2130706432
s_nop 0
v_cndmask_b32 v61, v62, v61, s[36:37]
buffer_load_dwordx2 v[12:13], v61, s[8:11], 0 offen
v_lshrrev_b32 v60, 24, v7
v_cmp_lt_u32 s[38:39], v2, v60
v_and_b32 v61, s55, v7
v_add_u32 v61, v61, v98
v_mov_b32 v62, 2130706432
s_nop 0
v_cndmask_b32 v61, v62, v61, s[38:39]
buffer_load_dwordx2 v[14:15], v61, s[8:11], 0 offen
v_mov_b32 v114, 0
v_mov_b32 v115, 0
v_lshrrev_b32 v60, 24, v114
v_cmp_lt_u32 s[40:41], v2, v60
v_and_b32 v61, s55, v114
v_add_u32 v61, v61, v98
v_mov_b32 v62, 2130706432
s_nop 0
v_cndmask_b32 v61, v62, v61, s[40:41]
buffer_load_dwordx2 v[16:17], v61, s[8:11], 0 offen
v_lshrrev_b32 v60, 24, v115
v_cmp_lt_u32 s[42:43], v2, v60
v_and_b32 v61, s55, v115
v_add_u32 v61, v61, v98
v_mov_b32 v62, 2130706432
s_nop 0
v_cndmask_b32 v61, v62, v61, s[42:43]
buffer_load_dwordx2 v[18:19], v61, s[8:11], 0 offen
s_branch L_f_slots
L_f_fits:
ds_bpermute_b32 v32, v32, v67
ds_bpermute_b32 v33, v33, v67
ds_bpermute_b32 v34, v34, v67
ds_bpermute_b32 v35, v35, v67
ds_bpermute_b32 v36, v36, v67
ds_bpermute_b32 v37, v37, v67
s_lshl_b32 s30, s23, 2
v_readlane_b32 s27, v67, s30
v_readlane_b32 s59, v64, s30
s_waitcnt lgkmcnt(0)
v_add_lshl_u32 v32, v32, v24, 2
v_add_lshl_u32 v33, v33, v25, 2
v_add_lshl_u32 v34, v34, v26, 2
v_add_lshl_u32 v35, v35, v27, 2
v_add_lshl_u32 v36, v36, v28, 2
v_add_lshl_u32 v37, v37, v29, 2
s_mov_b64 exec, s[32:33]
ds_write_b32 v32, v8 offset:1344
ds_write_b32 v32, v9 offset:19776
s_mov_b64 exec, s[34:35]
ds_write_b32 v33, v10 offset:1344
ds_write_b32 v33, v11 offset:19776
s_mov_b64 exec, s[36:37]
ds_write_b32 v34, v12 offset:1344
ds_write_b32 v34, v13 offset:19776
s_mov_b64 exec, s[38:39]
ds_write_b32 v35, v14 offset:1344
ds_write_b32 v35, v15 offset:19776
s_mov_b64 exec, s[40:41]
ds_write_b32 v36, v16 offset:1344
ds_write_b32 v36, v17 offset:19776
s_mov_b64 exec, s[42:43]
ds_write_b32 v37, v18 offset:1344
ds_write_b32 v37, v19 offset:19776
s_mov_b64 exec, -1
s_cmp_ge_u32 s23, s22
s_cbranch_scc1 L_f_nopad
s_add_u32 s29, s27, s59
s_sub_u32 s30, 0, s59
s_and_b32 s30, s30, 31
v_add_u32 v60, s29, v1
v_lshlrev_b32 v60, 2, v60
v_mov_b32 v61, 2130706432
v_mov_b32 v62, 0
v_cmp_gt_u32 vcc, s30, v1
s_and_saveexec_b64 s[52:53], vcc
s_cbranch_execz L_f_nopad2
ds_write_b32 v60, v61 offset:1344
ds_write_b32 v60, v62 offset:19776
L_f_nopad2:
s_mov_b64 exec, s[52:53]
L_f_nopad:
s_waitcnt lgkmcnt(0)
s_barrier
L_f_main:
s_cmp_lt_u32 s23, 13
s_cbranch_scc1 L_f_wl_d
s_cmp_eq_u32 s57, 0x77
s_cbranch_scc1 L_f_wl_d
s_mov_b32 s57, 0x77
s_sub_u32 s30, s23, 13
s_lshl_b32 s30, s30, 10
s_add_u32 m0, s30, 38208
v_lshl_add_u32 v42, v1, 4, s30
v_add_u32 v42, 0, v42
buffer_load_dwordx4 v42, s[16:19], 0 offen lds
s_add_u32 m0, s30, 41280
v_lshl_add_u32 v42, v1, 4, s30
v_add_u32 v42, 3072, v42
buffer_load_dwordx4 v42, s[16:19], 0 offen lds
s_cmp_eq_u32 s23, 15
s_cbranch_scc1 L_f_wl_d
s_add_u32 m0, s30, 44352
v_lshl_add_u32 v42, v1, 4, s30
v_add_u32 v42, 6144, v42
buffer_load_dwordx4 v42, s[16:19], 0 offen lds
L_f_wl_d:
s_cmp_ge_u32 s23, s22
s_cbranch_scc1 L_f_mdone
s_add_u32 s28, s59, 31
s_lshr_b32 s28, s28, 5
s_cmp_eq_u32 s28, 0
s_cbranch_scc1 L_f_mdone
s_lshl_b32 s30, s27, 2
v_add_u32 v96, s30, v105
v_add_u32 v97, s30, v106
ds_read_b128 v[84:87], v96
ds_read_b128 v[76:79], v97
ds_read_b128 v[80:83], v97 offset:64
s_waitcnt lgkmcnt(2)
s_add_u32 m0, s49, 0
v_add_u32 v84, v84, v88
v_add_u32 v85, v85, v89
v_add_u32 v86, v86, v90
v_add_u32 v87, v87, v91
buffer_load_dwordx4 v84, s[4:7], 0 offen offset:0 sc1 lds
buffer_load_dwordx4 v85, s[4:7], 0 offen offset:1024 sc1 lds
buffer_load_dwordx4 v86, s[4:7], 0 offen offset:2048 sc1 lds
buffer_load_dwordx4 v87, s[4:7], 0 offen offset:3072 sc1 lds
ds_read_b128 v[84:87], v96 offset:128
s_waitcnt lgkmcnt(1)
v_bfe_i32 v108, v76, v104, 1
v_bfe_i32 v109, v77, v104, 1
v_bfe_i32 v110, v78, v104, 1
v_bfe_i32 v111, v79, v104, 1
v_bfe_i32 v112, v80, v104, 1
v_bfe_i32 v113, v81, v104, 1
v_bfe_i32 v114, v82, v104, 1
v_bfe_i32 v115, v83, v104, 1
v_and_b32_sdwa v72, v108, v76 dst_sel:WORD_0 dst_unused:UNUSED_PAD src0_sel:WORD_0 src1_sel:WORD_0
v_and_b32_sdwa v73, v110, v78 dst_sel:WORD_0 dst_unused:UNUSED_PAD src0_sel:WORD_0 src1_sel:WORD_0
v_and_b32_sdwa v74, v112, v80 dst_sel:WORD_0 dst_unused:UNUSED_PAD src0_sel:WORD_0 src1_sel:WORD_0
v_and_b32_sdwa v75, v114, v82 dst_sel:WORD_0 dst_unused:UNUSED_PAD src0_sel:WORD_0 src1_sel:WORD_0
v_and_b32_sdwa v72, v109, v77 dst_sel:WORD_1 dst_unused:UNUSED_PRESERVE src0_sel:WORD_0 src1_sel:WORD_0
v_and_b32_sdwa v73, v111, v79 dst_sel:WORD_1 dst_unused:UNUSED_PRESERVE src0_sel:WORD_0 src1_sel:WORD_0
v_and_b32_sdwa v74, v113, v81 dst_sel:WORD_1 dst_unused:UNUSED_PRESERVE src0_sel:WORD_0 src1_sel:WORD_0
v_and_b32_sdwa v75, v115, v83 dst_sel:WORD_1 dst_unused:UNUSED_PRESERVE src0_sel:WORD_0 src1_sel:WORD_0
s_branch L_f_m_c0
L_f_main2:
s_cmp_ge_u32 s23, s22
s_cbranch_scc1 L_f_mdone
s_cmp_eq_u32 s28, 0
s_cbranch_scc1 L_f_mdone
s_add_u32 m0, s49, 0
v_add_u32 v84, v84, v88
v_add_u32 v85, v85, v89
v_add_u32 v86, v86, v90
v_add_u32 v87, v87, v91
buffer_load_dwordx4 v84, s[4:7], 0 offen offset:0 sc1 lds
buffer_load_dwordx4 v85, s[4:7], 0 offen offset:1024 sc1 lds
buffer_load_dwordx4 v86, s[4:7], 0 offen offset:2048 sc1 lds
buffer_load_dwordx4 v87, s[4:7], 0 offen offset:3072 sc1 lds
ds_read_b128 v[84:87], v96 offset:128
L_f_m_c0:
s_mov_b32 s29, 0
L_f_mloop:
s_add_u32 s30, s29, 1
s_cmp_lt_u32 s30, s28
s_waitcnt vmcnt(0) lgkmcnt(0)
s_cbranch_scc0 L_f_b0_noiss
s_add_u32 m0, s49, 4096
v_add_u32 v84, v84, v88
v_add_u32 v85, v85, v89
v_add_u32 v86, v86, v90
v_add_u32 v87, v87, v91
buffer_load_dwordx4 v84, s[4:7], 0 offen offset:0 sc1 lds
buffer_load_dwordx4 v85, s[4:7], 0 offen offset:1024 sc1 lds
buffer_load_dwordx4 v86, s[4:7], 0 offen offset:2048 sc1 lds
buffer_load_dwordx4 v87, s[4:7], 0 offen offset:3072 sc1 lds
L_f_b0_noiss:
ds_read_b64_tr_b16 v[56:57], v92 offset:0
ds_read_b64_tr_b16 v[58:59], v92 offset:512
ds_read_b64_tr_b16 v[60:61], v93 offset:0
ds_read_b64_tr_b16 v[62:63], v93 offset:512
ds_read_b64_tr_b16 v[64:65], v94 offset:0
ds_read_b64_tr_b16 v[66:67], v94 offset:512
ds_read_b64_tr_b16 v[68:69], v95 offset:0
ds_read_b64_tr_b16 v[70:71], v95 offset:512
ds_read_b128 v[76:79], v97 offset:128
ds_read_b128 v[80:83], v97 offset:192
ds_read_b128 v[84:87], v96 offset:256
s_waitcnt lgkmcnt(9)
v_mfma_f32_16x16x32_bf16 v[40:43], v[56:59], v[72:75], v[40:43]
s_waitcnt lgkmcnt(7)
v_mfma_f32_16x16x32_bf16 v[44:47], v[60:63], v[72:75], v[44:47]
s_waitcnt lgkmcnt(5)
v_mfma_f32_16x16x32_bf16 v[48:51], v[64:67], v[72:75], v[48:51]
s_waitcnt lgkmcnt(3)
v_mfma_f32_16x16x32_bf16 v[52:55], v[68:71], v[72:75], v[52:55]
s_add_u32 s29, s29, 1
s_cmp_ge_u32 s29, s28
s_cbranch_scc1 L_f_mdone
s_waitcnt lgkmcnt(1)
v_bfe_i32 v108, v76, v104, 1
v_bfe_i32 v109, v77, v104, 1
v_bfe_i32 v110, v78, v104, 1
v_bfe_i32 v111, v79, v104, 1
v_bfe_i32 v112, v80, v104, 1
v_bfe_i32 v113, v81, v104, 1
v_bfe_i32 v114, v82, v104, 1
v_bfe_i32 v115, v83, v104, 1
v_and_b32_sdwa v72, v108, v76 dst_sel:WORD_0 dst_unused:UNUSED_PAD src0_sel:WORD_0 src1_sel:WORD_0
v_and_b32_sdwa v73, v110, v78 dst_sel:WORD_0 dst_unused:UNUSED_PAD src0_sel:WORD_0 src1_sel:WORD_0
v_and_b32_sdwa v74, v112, v80 dst_sel:WORD_0 dst_unused:UNUSED_PAD src0_sel:WORD_0 src1_sel:WORD_0
v_and_b32_sdwa v75, v114, v82 dst_sel:WORD_0 dst_unused:UNUSED_PAD src0_sel:WORD_0 src1_sel:WORD_0
v_and_b32_sdwa v72, v109, v77 dst_sel:WORD_1 dst_unused:UNUSED_PRESERVE src0_sel:WORD_0 src1_sel:WORD_0
v_and_b32_sdwa v73, v111, v79 dst_sel:WORD_1 dst_unused:UNUSED_PRESERVE src0_sel:WORD_0 src1_sel:WORD_0
v_and_b32_sdwa v74, v113, v81 dst_sel:WORD_1 dst_unused:UNUSED_PRESERVE src0_sel:WORD_0 src1_sel:WORD_0
v_and_b32_sdwa v75, v115, v83 dst_sel:WORD_1 dst_unused:UNUSED_PRESERVE src0_sel:WORD_0 src1_sel:WORD_0
s_add_u32 s30, s29, 1
s_cmp_lt_u32 s30, s28
s_waitcnt vmcnt(0) lgkmcnt(0)
s_cbranch_scc0 L_f_b1_noiss
s_add_u32 m0, s49, 0
v_add_u32 v84, v84, v88
v_add_u32 v85, v85, v89
v_add_u32 v86, v86, v90
v_add_u32 v87, v87, v91
buffer_load_dwordx4 v84, s[4:7], 0 offen offset:0 sc1 lds
buffer_load_dwordx4 v85, s[4:7], 0 offen offset:1024 sc1 lds
buffer_load_dwordx4 v86, s[4:7], 0 offen offset:2048 sc1 lds
buffer_load_dwordx4 v87, s[4:7], 0 offen offset:3072 sc1 lds
L_f_b1_noiss:
ds_read_b64_tr_b16 v[56:57], v92 offset:4096
ds_read_b64_tr_b16 v[58:59], v92 offset:4608
ds_read_b64_tr_b16 v[60:61], v93 offset:4096
ds_read_b64_tr_b16 v[62:63], v93 offset:4608
ds_read_b64_tr_b16 v[64:65], v94 offset:4096
ds_read_b64_tr_b16 v[66:67], v94 offset:4608
ds_read_b64_tr_b16 v[68:69], v95 offset:4096
ds_read_b64_tr_b16 v[70:71], v95 offset:4608
ds_read_b128 v[76:79], v97 offset:256
ds_read_b128 v[80:83], v97 offset:320
ds_read_b128 v[84:87], v96 offset:384
s_waitcnt lgkmcnt(9)
v_mfma_f32_16x16x32_bf16 v[40:43], v[56:59], v[72:75], v[40:43]
s_waitcnt lgkmcnt(7)
v_mfma_f32_16x16x32_bf16 v[44:47], v[60:63], v[72:75], v[44:47]
s_waitcnt lgkmcnt(5)
v_mfma_f32_16x16x32_bf16 v[48:51], v[64:67], v[72:75], v[48:51]
s_waitcnt lgkmcnt(3)
v_mfma_f32_16x16x32_bf16 v[52:55], v[68:71], v[72:75], v[52:55]
s_add_u32 s29, s29, 1
s_cmp_ge_u32 s29, s28
s_cbranch_scc1 L_f_mdone
s_waitcnt lgkmcnt(1)
v_bfe_i32 v108, v76, v104, 1
v_bfe_i32 v109, v77, v104, 1
v_bfe_i32 v110, v78, v104, 1
v_bfe_i32 v111, v79, v104, 1
v_bfe_i32 v112, v80, v104, 1
v_bfe_i32 v113, v81, v104, 1
v_bfe_i32 v114, v82, v104, 1
v_bfe_i32 v115, v83, v104, 1
v_and_b32_sdwa v72, v108, v76 dst_sel:WORD_0 dst_unused:UNUSED_PAD src0_sel:WORD_0 src1_sel:WORD_0
v_and_b32_sdwa v73, v110, v78 dst_sel:WORD_0 dst_unused:UNUSED_PAD src0_sel:WORD_0 src1_sel:WORD_0
v_and_b32_sdwa v74, v112, v80 dst_sel:WORD_0 dst_unused:UNUSED_PAD src0_sel:WORD_0 src1_sel:WORD_0
v_and_b32_sdwa v75, v114, v82 dst_sel:WORD_0 dst_unused:UNUSED_PAD src0_sel:WORD_0 src1_sel:WORD_0
v_and_b32_sdwa v72, v109, v77 dst_sel:WORD_1 dst_unused:UNUSED_PRESERVE src0_sel:WORD_0 src1_sel:WORD_0
v_and_b32_sdwa v73, v111, v79 dst_sel:WORD_1 dst_unused:UNUSED_PRESERVE src0_sel:WORD_0 src1_sel:WORD_0
v_and_b32_sdwa v74, v113, v81 dst_sel:WORD_1 dst_unused:UNUSED_PRESERVE src0_sel:WORD_0 src1_sel:WORD_0
v_and_b32_sdwa v75, v115, v83 dst_sel:WORD_1 dst_unused:UNUSED_PRESERVE src0_sel:WORD_0 src1_sel:WORD_0
v_add_u32 v96, 256, v96
v_add_u32 v97, 256, v97
s_branch L_f_mloop
L_f_mdone:
s_cmp_eq_u32 s31, 0
s_cbranch_scc1 L_f_epi
s_lshl_b32 s24, s25, 8
s_add_u32 s25, s25, 1
s_cmp_ge_u32 s24, s50
s_cbranch_scc1 L_f_epi
s_waitcnt lgkmcnt(0)
s_barrier
s_cmp_lg_u32 s23, 0
s_cbranch_scc1 L_f_nz2
v_mov_b32 v60, 0
v_lshlrev_b32 v61, 2, v1
ds_write_b32 v61, v60
L_f_nz2:
v_add_u32 v61, -1, v116
v_ashrrev_i32 v61, 4, v61
v_subrev_u32 v62, s24, v117
v_sub_u32 v63, 1, v62
v_max_i32 v63, 1, v63
v_and_b32 v64, 3, v0
v_add_u32 v63, v63, v64
v_sub_u32 v64, 256, v62
v_min_i32 v61, v61, v64
L_f_bld1loop:
v_cmp_le_i32 vcc, v63, v61
s_and_saveexec_b64 s[52:53], vcc
s_cbranch_execz L_f_bld1done
v_lshlrev_b32 v64, 4, v63
v_sub_u32 v64, v116, v64
v_min_u32 v64, 16, v64
v_lshl_add_u32 v65, v63, 7, v118
v_lshl_or_b32 v64, v64, 24, v65
v_add_u32 v65, v62, v63
v_lshlrev_b32 v65, 2, v65
ds_write_b32 v65, v64 offset:316
v_add_u32 v63, 4, v63
s_branch L_f_bld1loop
L_f_bld1done:
s_mov_b64 exec, -1
s_waitcnt lgkmcnt(0)
s_barrier
ds_read_b32 v110, v119 offset:320
ds_read_b32 v111, v119 offset:576
ds_read_b32 v112, v119 offset:832
ds_read_b32 v113, v119 offset:1088
s_waitcnt lgkmcnt(0)
v_lshrrev_b32 v60, 4, v0
v_add_u32 v60, s24, v60
v_cmp_gt_u32 vcc, s50, v60
v_add_u32 v60, 64, v60
s_nop 0
v_cndmask_b32 v110, 0, v110, vcc
v_cmp_gt_u32 vcc, s50, v60
v_add_u32 v60, 64, v60
s_nop 0
v_cndmask_b32 v111, 0, v111, vcc
v_cmp_gt_u32 vcc, s50, v60
v_add_u32 v60, 64, v60
s_nop 0
v_cndmask_b32 v112, 0, v112, vcc
v_cmp_gt_u32 vcc, s50, v60
v_add_u32 v60, 64, v60
s_nop 0
v_cndmask_b32 v113, 0, v113, vcc
v_lshrrev_b32 v60, 24, v110
v_cmp_lt_u32 s[32:33], v2, v60
v_and_b32 v61, s55, v110
v_add_u32 v61, v61, v98
v_mov_b32 v62, 2130706432
s_nop 0
v_cndmask_b32 v61, v62, v61, s[32:33]
buffer_load_dwordx2 v[8:9], v61, s[8:11], 0 offen
v_lshrrev_b32 v60, 24, v111
v_cmp_lt_u32 s[34:35], v2, v60
v_and_b32 v61, s55, v111
v_add_u32 v61, v61, v98
v_mov_b32 v62, 2130706432
s_nop 0
v_cndmask_b32 v61, v62, v61, s[34:35]
buffer_load_dwordx2 v[10:11], v61, s[8:11], 0 offen
v_lshrrev_b32 v60, 24, v112
v_cmp_lt_u32 s[36:37], v2, v60
v_and_b32 v61, s55, v112
v_add_u32 v61, v61, v98
v_mov_b32 v62, 2130706432
s_nop 0
v_cndmask_b32 v61, v62, v61, s[36:37]
buffer_load_dwordx2 v[12:13], v61, s[8:11], 0 offen
v_lshrrev_b32 v60, 24, v113
v_cmp_lt_u32 s[38:39], v2, v60
v_and_b32 v61, s55, v113
v_add_u32 v61, v61, v98
v_mov_b32 v62, 2130706432
s_nop 0
v_cndmask_b32 v61, v62, v61, s[38:39]
buffer_load_dwordx2 v[14:15], v61, s[8:11], 0 offen
v_mov_b32 v114, 0
v_mov_b32 v115, 0
v_lshrrev_b32 v60, 24, v114
v_cmp_lt_u32 s[40:41], v2, v60
v_and_b32 v61, s55, v114
v_add_u32 v61, v61, v98
v_mov_b32 v62, 2130706432
s_nop 0
v_cndmask_b32 v61, v62, v61, s[40:41]
buffer_load_dwordx2 v[16:17], v61, s[8:11], 0 offen
v_lshrrev_b32 v60, 24, v115
v_cmp_lt_u32 s[42:43], v2, v60
v_and_b32 v61, s55, v115
v_add_u32 v61, v61, v98
v_mov_b32 v62, 2130706432
s_nop 0
v_cndmask_b32 v61, v62, v61, s[42:43]
buffer_load_dwordx2 v[18:19], v61, s[8:11], 0 offen
s_branch L_f_slots
L_f_epi:
s_cmp_ge_u32 s23, s22
s_cbranch_scc1 L_f_epid
s_nop 7
s_nop 1
v_cvt_pk_bf16_f32 v56, v40, v41
v_cvt_pk_bf16_f32 v57, v42, v43
v_cvt_pk_bf16_f32 v58, v44, v45
v_cvt_pk_bf16_f32 v59, v46, v47
v_cvt_pk_bf16_f32 v60, v48, v49
v_cvt_pk_bf16_f32 v61, v50, v51
v_cvt_pk_bf16_f32 v62, v52, v53
v_cvt_pk_bf16_f32 v63, v54, v55
s_cmp_eq_u32 s58, 1
s_cbranch_scc1 L_f_nogemm
s_cmp_eq_u32 s31, 0
s_cbranch_scc1 L_f_have_w
v_bfe_u32 v65, v1, 2, 2
v_and_b32 v66, 3, v1
v_lshl_add_u32 v64, v3, 2, v65
v_lshlrev_b32 v64, 7, v64
v_lshl_add_u32 v64, v66, 3, v64
v_add_u32 v64, 38208, v64
ds_read_b64_tr_b16 v[8:9], v64 offset:0
ds_read_b64_tr_b16 v[10:11], v64 offset:2048
ds_read_b64_tr_b16 v[12:13], v64 offset:4096
ds_read_b64_tr_b16 v[14:15], v64 offset:6144
ds_read_b64_tr_b16 v[16:17], v64 offset:32
ds_read_b64_tr_b16 v[18:19], v64 offset:2080
ds_read_b64_tr_b16 v[20:21], v64 offset:4128
ds_read_b64_tr_b16 v[22:23], v64 offset:6176
ds_read_b64_tr_b16 v[24:25], v64 offset:64
ds_read_b64_tr_b16 v[26:27], v64 offset:2112
ds_read_b64_tr_b16 v[28:29], v64 offset:4160
ds_read_b64_tr_b16 v[30:31], v64 offset:6208
ds_read_b64_tr_b16 v[32:33], v64 offset:96
ds_read_b64_tr_b16 v[34:35], v64 offset:2144
ds_read_b64_tr_b16 v[36:37], v64 offset:4192
ds_read_b64_tr_b16 v[38:39], v64 offset:6240
L_f_have_w:
s_waitcnt lgkmcnt(0)
v_mfma_f32_16x16x32_bf16 v[40:43], v[8:11], v[56:59], 0
v_mfma_f32_16x16x32_bf16 v[44:47], v[16:19], v[56:59], 0
v_mfma_f32_16x16x32_bf16 v[48:51], v[24:27], v[56:59], 0
v_mfma_f32_16x16x32_bf16 v[52:55], v[32:35], v[56:59], 0
v_mfma_f32_16x16x32_bf16 v[40:43], v[12:15], v[60:63], v[40:43]
v_mfma_f32_16x16x32_bf16 v[44:47], v[20:23], v[60:63], v[44:47]
v_mfma_f32_16x16x32_bf16 v[48:51], v[28:31], v[60:63], v[48:51]
v_mfma_f32_16x16x32_bf16 v[52:55], v[36:39], v[60:63], v[52:55]
s_nop 7
s_nop 1
v_cvt_pk_bf16_f32 v56, v40, v41
v_cvt_pk_bf16_f32 v57, v42, v43
v_cvt_pk_bf16_f32 v58, v44, v45
v_cvt_pk_bf16_f32 v59, v46, v47
v_cvt_pk_bf16_f32 v60, v48, v49
v_cvt_pk_bf16_f32 v61, v50, v51
v_cvt_pk_bf16_f32 v62, v52, v53
v_cvt_pk_bf16_f32 v63, v54, v55
s_mov_b32 s12, s44
s_mov_b32 s13, s45
L_f_nogemm:
v_mul_u32_u24 v64, 144, v2
v_lshl_add_u32 v64, v3, 3, v64
v_add_u32 v64, s49, v64
ds_write_b64 v64, v[56:57] offset:0
ds_write_b64 v64, v[58:59] offset:32
ds_write_b64 v64, v[60:61] offset:64
ds_write_b64 v64, v[62:63] offset:96
v_lshrrev_b32 v65, 3, v1
v_mul_u32_u24 v65, 144, v65
v_and_b32 v66, 7, v1
v_lshl_add_u32 v65, v66, 4, v65
v_add_u32 v65, s49, v65
ds_read_b128 v[68:71], v65
ds_read_b128 v[72:75], v65 offset:1152
s_add_u32 s30, s21, s23
s_lshl_b32 s30, s30, 11
v_lshlrev_b32 v64, 4, v1
s_waitcnt lgkmcnt(1)
buffer_store_dwordx4 v[68:71], v64, s[12:15], s30 offen sc1
s_waitcnt lgkmcnt(0)
buffer_store_dwordx4 v[72:75], v64, s[12:15], s30 offen offset:1024 sc1
L_f_epid:
s_cmp_eq_u32 s58, 2
s_cbranch_scc1 L_f_fin
s_waitcnt vmcnt(0)
s_barrier
s_cmp_lg_u32 s23, 14
s_cbranch_scc1 L_f_gb_wait
s_and_b32 s30, s2, 15
s_lshl_b32 s30, s30, 7
s_add_u32 s30, s30, 7602176
v_mov_b32 v60, s30
v_mov_b32 v61, 1
s_mov_b64 exec, 1
buffer_atomic_add v61, v60, s[8:11], 0 offen sc0 sc1
s_waitcnt vmcnt(0)
v_readfirstlane_b32 s30, v61
s_cmp_eq_u32 s30, 15
s_cbranch_scc0 L_f_gb_member
v_mov_b32 v60, 7604224
v_mov_b32 v61, 1
buffer_atomic_add v61, v60, s[8:11], 0 offen sc0 sc1
s_waitcnt vmcnt(0)
v_readfirstlane_b32 s30, v61
s_cmp_eq_u32 s30, 15
s_cbranch_scc0 L_f_gb_member
s_mov_b64 exec, 0xffff
v_lshlrev_b32 v60, 7, v1
v_add_u32 v60, 7606272, v60
v_mov_b32 v61, 1
buffer_store_dword v61, v60, s[8:11], 0 offen sc1
s_mov_b64 exec, 1
L_f_gb_member:
s_and_b32 s30, s2, 15
s_lshl_b32 s30, s30, 7
s_add_u32 s30, s30, 7606272
v_mov_b32 v60, s30
s_mov_b32 s29, 0
L_f_gb_poll:
buffer_load_dword v61, v60, s[8:11], 0 offen sc1
s_waitcnt vmcnt(0)
v_readfirstlane_b32 s30, v61
s_cmp_eq_u32 s30, 1
s_cbranch_scc1 L_f_gb_done
s_add_u32 s29, s29, 1
s_cmp_lt_u32 s29, 0x100000
s_cbranch_scc1 L_f_gb_poll
L_f_gb_done:
s_mov_b64 exec, -1
s_branch L_f_gb_join
L_f_gb_wait:
s_cmp_lg_u32 s31, 0
s_cbranch_scc1 L_f_gb_join
s_cmp_ge_u32 s23, s22
s_cbranch_scc1 L_f_gb_join
v_bfe_u32 v65, v1, 2, 2
v_and_b32 v66, 3, v1
v_lshl_add_u32 v64, v3, 2, v65
v_lshlrev_b32 v64, 7, v64
v_lshl_add_u32 v64, v66, 3, v64
v_add_u32 v64, 38208, v64
ds_read_b64_tr_b16 v[8:9], v64 offset:0
ds_read_b64_tr_b16 v[10:11], v64 offset:2048
ds_read_b64_tr_b16 v[12:13], v64 offset:4096
ds_read_b64_tr_b16 v[14:15], v64 offset:6144
ds_read_b64_tr_b16 v[16:17], v64 offset:32
ds_read_b64_tr_b16 v[18:19], v64 offset:2080
ds_read_b64_tr_b16 v[20:21], v64 offset:4128
ds_read_b64_tr_b16 v[22:23], v64 offset:6176
ds_read_b64_tr_b16 v[24:25], v64 offset:64
ds_read_b64_tr_b16 v[26:27], v64 offset:2112
ds_read_b64_tr_b16 v[28:29], v64 offset:4160
ds_read_b64_tr_b16 v[30:31], v64 offset:6208
ds_read_b64_tr_b16 v[32:33], v64 offset:96
ds_read_b64_tr_b16 v[34:35], v64 offset:2144
ds_read_b64_tr_b16 v[36:37], v64 offset:4192
ds_read_b64_tr_b16 v[38:39], v64 offset:6240
s_add_u32 s28, s59, 31
s_lshr_b32 s28, s28, 5
s_lshl_b32 s30, s27, 2
v_add_u32 v96, s30, v105
v_add_u32 v97, s30, v106
ds_read_b128 v[84:87], v96
ds_read_b128 v[76:79], v97
ds_read_b128 v[80:83], v97 offset:64
v_mov_b32 v40, 0
v_mov_b32 v41, 0
v_mov_b32 v42, 0
v_mov_b32 v43, 0
v_mov_b32 v44, 0
v_mov_b32 v45, 0
v_mov_b32 v46, 0
v_mov_b32 v47, 0
v_mov_b32 v48, 0
v_mov_b32 v49, 0
v_mov_b32 v50, 0
v_mov_b32 v51, 0
v_mov_b32 v52, 0
v_mov_b32 v53, 0
v_mov_b32 v54, 0
v_mov_b32 v55, 0
s_waitcnt lgkmcnt(0)
v_bfe_i32 v108, v76, v104, 1
v_bfe_i32 v109, v77, v104, 1
v_bfe_i32 v110, v78, v104, 1
v_bfe_i32 v111, v79, v104, 1
v_bfe_i32 v112, v80, v104, 1
v_bfe_i32 v113, v81, v104, 1
v_bfe_i32 v114, v82, v104, 1
v_bfe_i32 v115, v83, v104, 1
v_and_b32_sdwa v72, v108, v76 dst_sel:WORD_0 dst_unused:UNUSED_PAD src0_sel:WORD_0 src1_sel:WORD_0
v_and_b32_sdwa v73, v110, v78 dst_sel:WORD_0 dst_unused:UNUSED_PAD src0_sel:WORD_0 src1_sel:WORD_0
v_and_b32_sdwa v74, v112, v80 dst_sel:WORD_0 dst_unused:UNUSED_PAD src0_sel:WORD_0 src1_sel:WORD_0
v_and_b32_sdwa v75, v114, v82 dst_sel:WORD_0 dst_unused:UNUSED_PAD src0_sel:WORD_0 src1_sel:WORD_0
v_and_b32_sdwa v72, v109, v77 dst_sel:WORD_1 dst_unused:UNUSED_PRESERVE src0_sel:WORD_0 src1_sel:WORD_0
v_and_b32_sdwa v73, v111, v79 dst_sel:WORD_1 dst_unused:UNUSED_PRESERVE src0_sel:WORD_0 src1_sel:WORD_0
v_and_b32_sdwa v74, v113, v81 dst_sel:WORD_1 dst_unused:UNUSED_PRESERVE src0_sel:WORD_0 src1_sel:WORD_0
v_and_b32_sdwa v75, v115, v83 dst_sel:WORD_1 dst_unused:UNUSED_PRESERVE src0_sel:WORD_0 src1_sel:WORD_0
L_f_gb_join:
s_barrier
s_mov_b32 s58, 2
s_add_u32 s4, s8, 8385536
s_addc_u32 s5, s9, 0
s_cmp_eq_u32 s31, 0
s_cbranch_scc1 L_f_main2
v_mov_b32 v40, 0
v_mov_b32 v41, 0
v_mov_b32 v42, 0
v_mov_b32 v43, 0
v_mov_b32 v44, 0
v_mov_b32 v45, 0
v_mov_b32 v46, 0
v_mov_b32 v47, 0
v_mov_b32 v48, 0
v_mov_b32 v49, 0
v_mov_b32 v50, 0
v_mov_b32 v51, 0
v_mov_b32 v52, 0
v_mov_b32 v53, 0
v_mov_b32 v54, 0
v_mov_b32 v55, 0
s_cmp_eq_u32 s31, 0
s_cbranch_scc1 L_f_main
s_branch L_f_slow0
L_f_fin:
L_f_end:
s_endpgm
L_f_codeend:
.section .rodata,"a"
.p2align 6
.amdhsa_kernel gather_scatter__spectral_conv_sgc__graph_kernel
  .amdhsa_next_free_vgpr 76
  .amdhsa_next_free_sgpr 64
  .amdhsa_accum_offset 76
  .amdhsa_group_segment_fixed_size 0
  .amdhsa_kernarg_size 64
  .amdhsa_user_sgpr_count 2
  .amdhsa_user_sgpr_kernarg_segment_ptr 1
  .amdhsa_system_sgpr_workgroup_id_x 1
.end_amdhsa_kernel
.p2align 6
.amdhsa_kernel hops_kernel
  .amdhsa_next_free_vgpr 128
  .amdhsa_next_free_sgpr 64
  .amdhsa_accum_offset 128
  .amdhsa_group_segment_fixed_size 0
  .amdhsa_kernarg_size 64
  .amdhsa_user_sgpr_count 2
  .amdhsa_user_sgpr_kernarg_segment_ptr 1
  .amdhsa_system_sgpr_workgroup_id_x 1
.end_amdhsa_kernel
```
